```python
import torch

def _softmax(x, axis=-1):
    return torch.softmax(x, dim=axis)
def _gelu(x):
    return torch.nn.functional.gelu(x, approximate="tanh")
def _silu(x):
    return torch.nn.functional.silu(x)
def _sigmoid(x):
    return torch.sigmoid(x)
def _layernorm(x, axis=-1, eps=1e-5):
    m = x.mean(dim=axis, keepdim=True)
    v = x.var(dim=axis, keepdim=True, unbiased=False)
    return (x - m) / torch.sqrt(v + eps)
def _scatter_add(tgt, idx, src, axis=0):
    return tgt.clone().index_add_(axis, idx, src)
def _segment_sum(src, seg, n):
    out = torch.zeros((n,) + src.shape[1:], dtype=src.dtype)
    return out.index_add_(0, seg, src)
def _pad(x, pw):
    flat = tuple(v for pair in reversed(pw) for v in pair)
    return torch.nn.functional.pad(x, flat)

kernel_name = 'standalone__mha_softmax__sampling'

def setup_inputs():

    _w = (lambda a: (lambda t: t.to(torch.bfloat16) if t.is_floating_point() else t)(torch.as_tensor(a)))
    B, H, Sq, Sk, D = 8, 32, 16, 2048, 128
    return {
        "q": _w((lambda *s: torch.randn(*s, dtype=torch.bfloat16) * 0.8)(B, H, Sq, D)),
        "k": _w((lambda *s: torch.randn(*s, dtype=torch.bfloat16) * 0.8)(B, H, Sk, D)),
        "v": _w((lambda *s: torch.randn(*s, dtype=torch.bfloat16) * 0.05)(B, H, Sk, D)),
    }

def reference(q, k, v):
    scale = q.shape[-1] ** -0.5
    scores = torch.einsum("bhqd,bhkd->bhqk", q, k) * scale
    p = _softmax(scores, axis=-1)
    return torch.einsum("bhqk,bhkd->bhqd", p, v)
```

```asm
; @launch grid=(256,1,1) block=(384,1,1) lds=140288
.amdgcn_target "amdgcn-amd-amdhsa--gfx950"
.text
.globl standalone__mha_softmax__sampling_kernel
.p2align 12
.p2align 8
.type standalone__mha_softmax__sampling_kernel,@function
standalone__mha_softmax__sampling_kernel:
    s_load_dwordx2 s[16:17], s[0:1], 0
    s_load_dwordx2 s[8:9], s[0:1], 8
    v_readfirstlane_b32 s3, v0
    s_cmpk_ge_u32 s2, 256
    s_cbranch_scc1 L_end
    s_mov_b32 s11, 0x20000
    s_cmpk_eq_u32 s3, 320
    s_cbranch_scc1 L_bal
    s_bitcmp1_b32 s2, 0
    s_cselect_b32 s66, 0x6212000, 0
    s_bitcmp1_b32 s2, 1
    s_cselect_b32 s4, 0x6deec00, 0
    s_xor_b32 s66, s66, s4
    s_bitcmp1_b32 s2, 2
    s_cselect_b32 s4, 0x3509800, 0
    s_xor_b32 s66, s66, s4
    s_bitcmp1_b32 s2, 3
    s_cselect_b32 s4, 0x1f12000, 0
    s_xor_b32 s66, s66, s4
    s_bitcmp1_b32 s2, 4
    s_cselect_b32 s4, 0x4ffe800, 0
    s_xor_b32 s66, s66, s4
    s_bitcmp1_b32 s2, 5
    s_cselect_b32 s4, 0x424800, 0
    s_xor_b32 s66, s66, s4
    s_bitcmp1_b32 s2, 6
    s_cselect_b32 s4, 0x23c800, 0
    s_xor_b32 s66, s66, s4
    s_bitcmp1_b32 s2, 7
    s_cselect_b32 s4, 0x4b3a000, 0
    s_xor_b32 s66, s66, s4
    s_lshr_b32 s32, s66, 19
    s_lshl_b32 s32, s32, 12
    s_cmp_lg_u32 s3, 0
    s_cbranch_scc1 L_c
    v_lshrrev_b32 v1, 4, v0
    v_xor_b32 v2, v1, v0
    v_lshlrev_b32 v2, 4, v2
    v_xor_b32 v3, 64, v2
    v_xor_b32 v4, 128, v2
    v_xor_b32 v5, 64, v4
    s_xor_b32 s67, s66, 0x3e800
    s_mov_b32 s6, 0x31800
    s_mov_b32 s7, s6
    s_xor_b64 s[68:69], s[66:67], s[6:7]
    s_mov_b32 s6, 0x29c00
    s_mov_b32 s7, s6
    s_xor_b64 s[70:71], s[66:67], s[6:7]
    s_xor_b64 s[72:73], s[68:69], s[6:7]
    s_movk_i32 s6, 0x5000
    s_mov_b32 s7, s6
    s_xor_b64 s[74:75], s[66:67], s[6:7]
    s_lshl_b32 s18, s11, 3
    s_mov_b32 s19, s11
    s_mov_b32 m0, s11
    s_waitcnt lgkmcnt(0)
    buffer_load_dwordx4 v2, s[16:19], s32 offen offset:0 nt lds
    s_xor_b64 s[76:77], s[68:69], s[6:7]
    s_xor_b64 s[78:79], s[70:71], s[6:7]
    s_xor_b64 s[80:81], s[72:73], s[6:7]
    buffer_load_dwordx4 v3, s[16:19], s32 offen offset:1024 nt lds
    s_mov_b32 s20, 0x15400
    s_mov_b32 s21, s20
    s_brev_b32 s10, 16
    buffer_load_dwordx4 v4, s[16:19], s32 offen offset:2048 nt lds
    s_movk_i32 s22, 0x400
    s_mov_b32 s27, 0
    s_mov_b64 vcc, 0
    buffer_load_dwordx4 v5, s[16:19], s32 offen offset:3072 nt lds
    v_mov_b32 v10, s11
    v_mov_b32 v11, 4
    s_load_dwordx2 s[40:41], s[0:1], 16
    s_mov_b32 m0, 0
L_hi:
    s_waitcnt vmcnt(21)
    buffer_load_dwordx4 v2, s[8:11], s66 offen nt lds
    s_add_u32 m0, m0, s22
    s_waitcnt vmcnt(21)
    buffer_load_dwordx4 v3, s[8:11], s67 offen nt lds
    s_add_u32 m0, m0, s22
    s_xor_b64 s[66:67], s[66:67], s[20:21]
    s_waitcnt vmcnt(21)
    buffer_load_dwordx4 v4, s[8:11], s68 offen nt lds
    s_add_u32 m0, m0, s22
    s_waitcnt vmcnt(21)
    buffer_load_dwordx4 v5, s[8:11], s69 offen nt lds
    s_add_u32 m0, m0, s22
    s_xor_b64 s[68:69], s[68:69], s[20:21]
    s_waitcnt vmcnt(21)
    buffer_load_dwordx4 v2, s[8:11], s70 offen nt lds
    s_add_u32 m0, m0, s22
    s_waitcnt vmcnt(21)
    buffer_load_dwordx4 v3, s[8:11], s71 offen nt lds
    s_add_u32 m0, m0, s22
    s_xor_b64 s[70:71], s[70:71], s[20:21]
    s_waitcnt vmcnt(21)
    buffer_load_dwordx4 v4, s[8:11], s72 offen nt lds
    s_add_u32 m0, m0, s22
    s_waitcnt vmcnt(21)
    buffer_load_dwordx4 v5, s[8:11], s73 offen nt lds
    s_add_u32 m0, m0, s22
    s_xor_b64 s[72:73], s[72:73], s[20:21]
    s_cbranch_vccz L_nbhi
    s_barrier
    ds_read_b32 v11, v10 offset:0x2300
L_nbhi:
    s_waitcnt vmcnt(21)
    buffer_load_dwordx4 v2, s[8:11], s74 offen nt lds
    s_add_u32 m0, m0, s22
    s_waitcnt vmcnt(21)
    buffer_load_dwordx4 v3, s[8:11], s75 offen nt lds
    s_add_u32 m0, m0, s22
    s_xor_b64 s[74:75], s[74:75], s[20:21]
    s_waitcnt vmcnt(21)
    buffer_load_dwordx4 v4, s[8:11], s76 offen nt lds
    s_add_u32 m0, m0, s22
    s_waitcnt vmcnt(21)
    buffer_load_dwordx4 v5, s[8:11], s77 offen nt lds
    s_add_u32 m0, m0, s22
    s_xor_b64 s[76:77], s[76:77], s[20:21]
    s_waitcnt vmcnt(21)
    buffer_load_dwordx4 v2, s[8:11], s78 offen nt lds
    s_add_u32 m0, m0, s22
    s_waitcnt vmcnt(21)
    buffer_load_dwordx4 v3, s[8:11], s79 offen nt lds
    s_add_u32 m0, m0, s22
    s_xor_b64 s[78:79], s[78:79], s[20:21]
    s_waitcnt vmcnt(21)
    buffer_load_dwordx4 v4, s[8:11], s80 offen nt lds
    s_add_u32 m0, m0, s22
    s_waitcnt vmcnt(21)
    buffer_load_dwordx4 v5, s[8:11], s81 offen nt lds
    s_add_u32 m0, m0, s22
    s_xor_b64 s[80:81], s[80:81], s[20:21]
L_join:
    s_waitcnt lgkmcnt(0)
    v_readfirstlane_b32 s26, v11
    s_bitset0_b32 m0, 17
    s_add_u32 s27, s27, 1
    s_ff0_i32_b32 s4, s27
    s_mov_b32 s20, 0x1a800
    s_cmp_eq_u32 s4, 0
    s_cselect_b32 s20, 0x15400, s20
    s_cmp_eq_u32 s4, 1
    s_cmovk_i32 s20, 0x400
    s_cmp_eq_u32 s4, 2
    s_cselect_b32 s20, 0x61000, s20
    s_cmp_eq_u32 s4, 3
    s_cselect_b32 s20, 0x60c00, s20
    s_mov_b32 s21, s20
    s_bitcmp1_b32 0x80000005, s27
    s_cbranch_scc1 L_rare
L_disp:
    s_bitcmp1_b32 s26, s27
    s_cbranch_scc1 L_hi
L_lo:
    s_waitcnt vmcnt(18)
    buffer_load_dwordx4 v2, s[8:11], s66 offen nt lds
    s_add_u32 m0, m0, s22
    s_waitcnt vmcnt(18)
    buffer_load_dwordx4 v3, s[8:11], s67 offen nt lds
    s_add_u32 m0, m0, s22
    s_xor_b64 s[66:67], s[66:67], s[20:21]
    s_waitcnt vmcnt(18)
    buffer_load_dwordx4 v4, s[8:11], s68 offen nt lds
    s_add_u32 m0, m0, s22
    s_waitcnt vmcnt(18)
    buffer_load_dwordx4 v5, s[8:11], s69 offen nt lds
    s_add_u32 m0, m0, s22
    s_xor_b64 s[68:69], s[68:69], s[20:21]
    s_waitcnt vmcnt(18)
    buffer_load_dwordx4 v2, s[8:11], s70 offen nt lds
    s_add_u32 m0, m0, s22
    s_waitcnt vmcnt(18)
    buffer_load_dwordx4 v3, s[8:11], s71 offen nt lds
    s_add_u32 m0, m0, s22
    s_xor_b64 s[70:71], s[70:71], s[20:21]
    s_waitcnt vmcnt(18)
    buffer_load_dwordx4 v4, s[8:11], s72 offen nt lds
    s_add_u32 m0, m0, s22
    s_waitcnt vmcnt(18)
    buffer_load_dwordx4 v5, s[8:11], s73 offen nt lds
    s_add_u32 m0, m0, s22
    s_xor_b64 s[72:73], s[72:73], s[20:21]
    s_cbranch_vccz L_nblo
    s_barrier
    ds_read_b32 v11, v10 offset:0x2300
L_nblo:
    s_waitcnt vmcnt(18)
    buffer_load_dwordx4 v2, s[8:11], s74 offen nt lds
    s_add_u32 m0, m0, s22
    s_waitcnt vmcnt(18)
    buffer_load_dwordx4 v3, s[8:11], s75 offen nt lds
    s_add_u32 m0, m0, s22
    s_xor_b64 s[74:75], s[74:75], s[20:21]
    s_waitcnt vmcnt(18)
    buffer_load_dwordx4 v4, s[8:11], s76 offen nt lds
    s_add_u32 m0, m0, s22
    s_waitcnt vmcnt(18)
    buffer_load_dwordx4 v5, s[8:11], s77 offen nt lds
    s_add_u32 m0, m0, s22
    s_xor_b64 s[76:77], s[76:77], s[20:21]
    s_waitcnt vmcnt(18)
    buffer_load_dwordx4 v2, s[8:11], s78 offen nt lds
    s_add_u32 m0, m0, s22
    s_waitcnt vmcnt(18)
    buffer_load_dwordx4 v3, s[8:11], s79 offen nt lds
    s_add_u32 m0, m0, s22
    s_xor_b64 s[78:79], s[78:79], s[20:21]
    s_waitcnt vmcnt(18)
    buffer_load_dwordx4 v4, s[8:11], s80 offen nt lds
    s_add_u32 m0, m0, s22
    s_waitcnt vmcnt(18)
    buffer_load_dwordx4 v5, s[8:11], s81 offen nt lds
    s_add_u32 m0, m0, s22
    s_xor_b64 s[80:81], s[80:81], s[20:21]
    s_branch L_join
.org standalone__mha_softmax__sampling_kernel + 1088, 0
L_c:
    s_load_dwordx2 s[12:13], s[0:1], 24
    s_lshl_b32 s14, s11, 3
    s_mov_b32 s15, s11
    s_sub_u32 s33, s3, 64
    v_and_b32 v0, 63, v0
    v_lshrrev_b32 v1, 4, v0
    s_mov_b32 s28, 0x3fb8aa3b
    s_mov_b32 s30, 0x3db504f3
    s_mov_b32 s31, 0xffff0000
    v_and_b32 v24, 15, v0
    v_xor_b32 v23, v1, v24
    v_lshlrev_b32 v23, 4, v23
    v_lshl_add_u32 v23, v24, 8, v23
    s_lshl_b32 s35, s33, 6
    v_add_u32 v8, s35, v23
    v_add_u32 v12, s11, v23
    v_xor_b32 v9, 64, v8
    v_xor_b32 v13, 64, v12
    v_xor_b32 v10, 128, v8
    v_xor_b32 v14, 128, v12
    v_xor_b32 v11, 64, v10
    v_xor_b32 v15, 64, v14
    v_lshrrev_b32 v2, 2, v0
    v_and_b32 v64, 7, v2
    v_lshlrev_b32 v64, 5, v64
    v_lshl_add_u32 v64, v2, 8, v64
    v_and_b32 v23, 3, v0
    v_lshl_add_u32 v64, v23, 3, v64
    v_xor_b32 v16, s33, v64
    v_xor_b32 v17, 32, v16
    v_lshlrev_b32 v27, 4, v0
    s_lshr_b32 s29, s33, 4
    s_mul_i32 s35, s29, 0x82
    s_and_b32 s35, s35, 0x408
    s_add_u32 s35, s35, 0x21000
    v_add_u32 v26, s35, v27
    v_add_u32 v27, 0x21800, v27
    v_lshlrev_b32 v29, 4, v24
    v_add_u32 v29, 0x22000, v29
    v_add_u32 v28, s29, v29
    s_lshl_b32 s35, s33, 5
    v_mul_u32_u24 v3, 112, v24
    v_lshl_add_u32 v3, v1, 3, v3
    v_add_u32 v3, s35, v3
    v_mul_u32_u24 v4, 112, v2
    v_lshl_add_u32 v4, v23, 4, v4
    v_add_u32 v4, s35, v4
    v_lshl_add_u32 v25, v23, 4, s33
    v_lshl_add_u32 v25, v2, 8, v25
    v_mov_b32 v80, 0
    v_mov_b32 v81, 0
    v_mov_b32 v82, 0
    v_mov_b32 v83, 0
    v_mov_b32 v84, 0
    v_mov_b32 v85, 0
    v_mov_b32 v86, 0
    v_mov_b32 v87, 0
    v_mov_b32 v20, 0xff800000
    v_mov_b32 v21, 0
    s_mov_b32 s25, 0
    s_mov_b32 s26, 0
    s_waitcnt lgkmcnt(0)
    s_barrier
    ds_read_b128 v[32:35], v12
    ds_read_b128 v[36:39], v13
    ds_read_b128 v[40:43], v14
    ds_read_b128 v[44:47], v15
    v_mov_b32 v12, v8
    v_mov_b32 v13, v9
    v_mov_b32 v14, v10
    v_mov_b32 v15, v11
    s_branch L_k1
L_p:
    s_set_gpr_idx_on s26, gpr_idx(SRC0)
    v_sub_f32 v64, v88, v20
    v_sub_f32 v65, v89, v20
    v_sub_f32 v66, v90, v20
    v_sub_f32 v67, v91, v20
    s_set_gpr_idx_off
    v_mul_f32 v64, s28, v64
    v_mul_f32 v65, s28, v65
    v_mul_f32 v66, s28, v66
    v_mul_f32 v67, s28, v67
    v_exp_f32 v64, v64
    v_exp_f32 v65, v65
    v_exp_f32 v66, v66
    v_exp_f32 v67, v67
    v_add_u32 v18, s25, v16
    v_add_u32 v19, s25, v17
    v_cvt_pk_bf16_f32 v6, v64, v65
    v_cvt_pk_bf16_f32 v7, v66, v67
    ds_write_b64 v26, v[6:7]
    v_add_f32 v23, v64, v65
    v_add_f32 v24, v66, v67
    v_add_f32 v23, v23, v24
    v_add_f32 v21, v21, v23
    v_mov_b32 v23, v21
    v_mov_b32 v24, v21
    s_addk_i32 s25, 0x4000
    s_bitset0_b32 s25, 17
    v_permlane32_swap_b32 v23, v24
    v_add_f32 v23, v23, v24
    v_mov_b32 v24, v23
    v_xor_b32 v26, s16, v26
    v_xor_b32 v27, s16, v27
    v_permlane16_swap_b32 v23, v24
    v_add_f32 v23, v23, v24
    ds_write_b32 v28, v23
    v_xor_b32 v28, s17, v28
    v_xor_b32 v29, s17, v29
    s_add_u32 s26, s26, 4
    s_waitcnt lgkmcnt(0)
    s_barrier
    ds_read_b128 v[68:71], v27 offset:0
    ds_read_b64_tr_b16 v[48:49], v18 offset:0
    ds_read_b64_tr_b16 v[50:51], v18 offset:4096
    ds_read_b64_tr_b16 v[52:53], v19 offset:0
    ds_read_b64_tr_b16 v[54:55], v19 offset:4096
    ds_read_b128 v[72:75], v27 offset:1024
    ds_read_b64_tr_b16 v[56:57], v18 offset:8192
    ds_read_b64_tr_b16 v[58:59], v18 offset:12288
    ds_read_b64_tr_b16 v[60:61], v19 offset:8192
    ds_read_b64_tr_b16 v[62:63], v19 offset:12288
    ds_read_b128 v[76:79], v29
    s_bitcmp0_b32 s26, 7
    s_waitcnt lgkmcnt(8)
    v_mfma_f32_16x16x32_bf16 v[80:83], v[48:51], v[68:71], v[80:83]
    s_waitcnt lgkmcnt(6)
    v_mfma_f32_16x16x32_bf16 v[84:87], v[52:55], v[68:71], v[84:87]
    s_waitcnt lgkmcnt(3)
    v_mfma_f32_16x16x32_bf16 v[80:83], v[56:59], v[72:75], v[80:83]
    s_waitcnt lgkmcnt(1)
    v_mfma_f32_16x16x32_bf16 v[84:87], v[60:63], v[72:75], v[84:87]
    s_cbranch_scc1 L_p
    s_waitcnt lgkmcnt(0)
    v_add_f32 v23, v76, v77
    v_add_f32 v24, v78, v79
    v_add_f32 v23, v23, v24
    v_rcp_f32 v30, v23
    s_nop 0
    v_pk_mul_f32 v[80:81], v[80:81], v[30:31] op_sel_hi:[1,0]
    v_pk_mul_f32 v[82:83], v[82:83], v[30:31] op_sel_hi:[1,0]
    v_pk_mul_f32 v[84:85], v[84:85], v[30:31] op_sel_hi:[1,0]
    v_pk_mul_f32 v[86:87], v[86:87], v[30:31] op_sel_hi:[1,0]
    v_cvt_pk_bf16_f32 v64, v80, v81
    v_cvt_pk_bf16_f32 v65, v82, v83
    v_cvt_pk_bf16_f32 v66, v84, v85
    v_cvt_pk_bf16_f32 v67, v86, v87
    ds_write2_b64 v3, v[64:65], v[66:67] offset1:4
    ds_read_b128 v[68:71], v4
    s_waitcnt lgkmcnt(0)
    buffer_store_dwordx4 v[68:71], v25, s[12:15], s32 offen
    s_endpgm
.org standalone__mha_softmax__sampling_kernel + 2176, 0
L_bal:
    s_load_dwordx2 s[12:13], s[0:1], 32
    s_mov_b64 exec, 0xffff
    v_mov_b32 v10, s11
    v_mov_b32 v11, 0x55555555
    ds_write_b32 v10, v11 offset:0x2300
    s_getreg_b32 s24, hwreg(HW_REG_HW_ID, 8, 4)
    s_getreg_b32 s25, hwreg(HW_REG_HW_ID, 13, 2)
    s_lshl4_add_u32 s24, s25, s24
    v_and_b32 v15, 15, v0
    v_lshlrev_b32 v15, 2, v15
    s_getreg_b32 s20, hwreg(HW_REG_XCC_ID, 0, 1)
    s_mul_i32 s20, s20, -8
    s_add_i32 s20, s20, 16
    s_mov_b32 s14, 64
    s_mov_b32 s15, s11
    s_mov_b32 s21, 0
    s_waitcnt lgkmcnt(0)
    s_barrier
    s_barrier
    s_barrier
    s_barrier
L_b:
    s_barrier
    s_add_u32 s21, s21, 1
    s_mov_b64 exec, 1
    v_mov_b32 v13, s21
    buffer_store_byte v13, off, s[12:15], s24
    s_mov_b64 exec, 0xffff
    buffer_load_dword v14, v15, s[12:15], 0 offen sc1
    s_barrier
    s_cmp_lg_u32 s21, 14
    s_cbranch_scc1 L_bx
    s_barrier
L_bx:
    s_waitcnt vmcnt(0)
    v_sad_u8 v16, v14, 0, 0
    s_lshl_b32 s23, s21, 5
    s_nop 1
    v_add_u32_dpp v16, v16, v16 row_shr:1 row_mask:0xf bank_mask:0xf bound_ctrl:1
    s_nop 1
    v_add_u32_dpp v16, v16, v16 row_shr:2 row_mask:0xf bank_mask:0xf bound_ctrl:1
    s_nop 1
    v_add_u32_dpp v16, v16, v16 row_shr:4 row_mask:0xf bank_mask:0xf bound_ctrl:1
    s_nop 1
    v_add_u32_dpp v16, v16, v16 row_shr:8 row_mask:0xf bank_mask:0xf bound_ctrl:1
    s_sub_i32 s23, s20, s23
    v_readlane_b32 s22, v16, 15
    s_nop 3
    s_add_i32 s22, s22, s23
    s_cmp_gt_i32 s22, -6
    s_cselect_b32 s23, 0x11111111, 0
    s_cmp_gt_i32 s22, -2
    s_cselect_b32 s23, 0x55555555, s23
    s_cmp_gt_i32 s22, 2
    s_cselect_b32 s23, 0x77777777, s23
    s_cmp_gt_i32 s22, 6
    s_cselect_b32 s23, -1, s23
    v_mov_b32 v11, s23
    ds_write_b32 v10, v11 offset:0x2300
    s_cmp_lt_u32 s21, 27
    s_waitcnt lgkmcnt(0)
    s_cbranch_scc1 L_b
    s_endpgm
L_k:
    s_barrier
L_k1:
    ds_read_b128 v[48:51], v12
    ds_read_b128 v[52:55], v13
    ds_read_b128 v[56:59], v14
    ds_read_b128 v[60:63], v15
    s_addk_i32 s25, 0x4000
    s_bitset0_b32 s25, 17
    s_waitcnt lgkmcnt(3)
    v_mfma_f32_16x16x32_bf16 v[64:67], v[48:51], v[32:35], 0
    s_waitcnt lgkmcnt(2)
    v_mfma_f32_16x16x32_bf16 v[64:67], v[52:55], v[36:39], v[64:67]
    s_waitcnt lgkmcnt(1)
    v_mfma_f32_16x16x32_bf16 v[64:67], v[56:59], v[40:43], v[64:67]
    s_waitcnt lgkmcnt(0)
    v_mfma_f32_16x16x32_bf16 v[64:67], v[60:63], v[44:47], v[64:67]
    v_add_u32 v12, s25, v8
    v_add_u32 v13, s25, v9
    v_add_u32 v14, s25, v10
    v_add_u32 v15, s25, v11
    s_nop 3
    v_max3_f32 v20, v20, v64, v65
    v_max3_f32 v20, v20, v66, v67
    v_cvt_pk_bf16_f32 v6, v64, v65
    v_cvt_pk_bf16_f32 v7, v66, v67
    v_lshlrev_b32 v64, 16, v6
    v_and_b32 v65, s31, v6
    v_lshlrev_b32 v66, 16, v7
    v_and_b32 v67, s31, v7
    v_mul_f32 v64, s30, v64
    v_mul_f32 v65, s30, v65
    v_mul_f32 v66, s30, v66
    v_mul_f32 v67, s30, v67
    v_cvt_pk_bf16_f32 v6, v64, v65
    v_cvt_pk_bf16_f32 v7, v66, v67
    s_set_gpr_idx_on s26, gpr_idx(DST)
    v_lshlrev_b32 v88, 16, v6
    v_and_b32 v89, s31, v6
    v_lshlrev_b32 v90, 16, v7
    v_and_b32 v91, s31, v7
    s_set_gpr_idx_off
    s_add_u32 s26, s26, 4
    s_bitcmp0_b32 s26, 7
    s_cbranch_scc1 L_k
    v_mov_b32 v23, v20
    s_movk_i32 s16, 0x800
    s_movk_i32 s17, 0x300
    v_permlane32_swap_b32 v23, v20
    v_max_f32 v20, v20, v23
    v_mov_b32 v23, v20
    s_mov_b32 s26, 0
    s_nop 0
    v_permlane16_swap_b32 v23, v20
    v_max_f32 v20, v20, v23
    ds_write_b32 v28, v20
    s_waitcnt lgkmcnt(0)
    s_barrier
    ds_read_b128 v[76:79], v29
    v_add_u32 v28, 0x100, v28
    v_add_u32 v29, 0x200, v29
    s_waitcnt lgkmcnt(0)
    v_max3_f32 v20, v76, v77, v78
    v_max_f32 v20, v20, v79
    v_cvt_pk_bf16_f32 v20, v20, v20
    v_and_b32 v20, s31, v20
    v_mul_f32 v20, s30, v20
    v_cvt_pk_bf16_f32 v20, v20, v20
    v_and_b32 v20, s31, v20
    s_branch L_p
L_rare:
    s_cmp_eq_u32 s27, 63
    s_cbranch_scc1 L_last
    s_cmp_eq_u32 s27, 32
    s_cbranch_scc1 L_tov
    s_cmp_eq_u32 s27, 34
    s_cbranch_scc1 L_x
    s_mov_b64 vcc, -1
    s_branch L_disp
L_x:
    s_barrier
    s_branch L_disp
L_tov:
    s_mov_b64 s[8:9], s[40:41]
    v_lshlrev_b32 v2, 1, v1
    v_xor_b32 v2, v2, v0
    v_lshlrev_b32 v2, 4, v2
    v_xor_b32 v3, 128, v2
    v_mov_b32 v4, v2
    v_mov_b32 v5, v3
    s_branch L_disp
L_last:
    buffer_load_dwordx4 v2, s[8:11], s66 offen nt lds
    s_add_u32 m0, m0, s22
    s_waitcnt vmcnt(40)
    buffer_load_dwordx4 v3, s[8:11], s67 offen nt lds
    s_add_u32 m0, m0, s22
    s_waitcnt vmcnt(40)
    buffer_load_dwordx4 v4, s[8:11], s68 offen nt lds
    s_add_u32 m0, m0, s22
    s_waitcnt vmcnt(40)
    buffer_load_dwordx4 v5, s[8:11], s69 offen nt lds
    s_add_u32 m0, m0, s22
    s_waitcnt vmcnt(40)
    buffer_load_dwordx4 v2, s[8:11], s70 offen nt lds
    s_add_u32 m0, m0, s22
    s_waitcnt vmcnt(40)
    buffer_load_dwordx4 v3, s[8:11], s71 offen nt lds
    s_add_u32 m0, m0, s22
    s_waitcnt vmcnt(40)
    buffer_load_dwordx4 v4, s[8:11], s72 offen nt lds
    s_add_u32 m0, m0, s22
    s_waitcnt vmcnt(40)
    buffer_load_dwordx4 v5, s[8:11], s73 offen nt lds
    s_add_u32 m0, m0, s22
    s_waitcnt vmcnt(40)
    buffer_load_dwordx4 v2, s[8:11], s74 offen nt lds
    s_add_u32 m0, m0, s22
    s_waitcnt vmcnt(40)
    buffer_load_dwordx4 v3, s[8:11], s75 offen nt lds
    s_add_u32 m0, m0, s22
    s_waitcnt vmcnt(40)
    buffer_load_dwordx4 v4, s[8:11], s76 offen nt lds
    s_add_u32 m0, m0, s22
    s_waitcnt vmcnt(40)
    buffer_load_dwordx4 v5, s[8:11], s77 offen nt lds
    s_add_u32 m0, m0, s22
    s_waitcnt vmcnt(40)
    buffer_load_dwordx4 v2, s[8:11], s78 offen nt lds
    s_add_u32 m0, m0, s22
    s_waitcnt vmcnt(40)
    buffer_load_dwordx4 v3, s[8:11], s79 offen nt lds
    s_add_u32 m0, m0, s22
    s_waitcnt vmcnt(40)
    buffer_load_dwordx4 v4, s[8:11], s80 offen nt lds
    s_add_u32 m0, m0, s22
    s_waitcnt vmcnt(40)
    buffer_load_dwordx4 v5, s[8:11], s81 offen nt lds
    s_waitcnt vmcnt(32)
    s_barrier
L_ldend:
    s_waitcnt vmcnt(16)
    s_barrier
    s_waitcnt vmcnt(0)
    s_barrier
L_end:
    s_endpgm
L_codeend:
.section .rodata,"a"
.p2align 6
.amdhsa_kernel standalone__mha_softmax__sampling_kernel
  .amdhsa_next_free_vgpr 216
  .amdhsa_next_free_sgpr 88
  .amdhsa_accum_offset 216
  .amdhsa_group_segment_fixed_size 0
  .amdhsa_kernarg_size 48
  .amdhsa_user_sgpr_count 2
  .amdhsa_user_sgpr_kernarg_segment_ptr 1
  .amdhsa_system_sgpr_workgroup_id_x 1
.end_amdhsa_kernel
```
